```python
import torch

def _softmax(x, axis=-1):
    return torch.softmax(x, dim=axis)
def _gelu(x):
    return torch.nn.functional.gelu(x, approximate="tanh")
def _silu(x):
    return torch.nn.functional.silu(x)
def _sigmoid(x):
    return torch.sigmoid(x)
def _layernorm(x, axis=-1, eps=1e-5):
    m = x.mean(dim=axis, keepdim=True)
    v = x.var(dim=axis, keepdim=True, unbiased=False)
    return (x - m) / torch.sqrt(v + eps)
def _scatter_add(tgt, idx, src, axis=0):
    return tgt.clone().index_add_(axis, idx, src)
def _segment_sum(src, seg, n):
    out = torch.zeros((n,) + src.shape[1:], dtype=src.dtype)
    return out.index_add_(0, seg, src)
def _pad(x, pw):
    flat = tuple(v for pair in reversed(pw) for v in pair)
    return torch.nn.functional.pad(x, flat)

kernel_name = 'standalone__mha_softmax__decode'

def setup_inputs():

    _w = (lambda a: (lambda t: t.to(torch.bfloat16) if t.is_floating_point() else t)(torch.as_tensor(a)))
    B, H, Sq, Sk, D = 1, 32, 1, 8192, 128
    return {
        "q": _w((lambda *s: torch.randn(*s, dtype=torch.bfloat16) * 0.8)(B, H, Sq, D)),
        "k": _w((lambda *s: torch.randn(*s, dtype=torch.bfloat16) * 0.8)(B, H, Sk, D)),
        "v": _w((lambda *s: torch.randn(*s, dtype=torch.bfloat16) * 0.05)(B, H, Sk, D)),
    }

def reference(q, k, v):
    scale = q.shape[-1] ** -0.5
    scores = torch.einsum("bhqd,bhkd->bhqk", q, k) * scale
    p = _softmax(scores, axis=-1)
    return torch.einsum("bhqk,bhkd->bhqd", p, v)
```

```asm
; @launch grid=(256,1,1) block=(192,1,1) lds=256
.amdgcn_target "amdgcn-amd-amdhsa--gfx950"
.text
.globl standalone__mha_softmax__decode_kernel
.p2align 12
.p2align 8
.type standalone__mha_softmax__decode_kernel,@function
standalone__mha_softmax__decode_kernel:
    s_cmp_ge_u32 s2, 256
    s_cbranch_scc1 L_end
    s_load_dwordx8 s[4:11], s[0:1], 0
    s_load_dwordx4 s[12:15], s[0:1], 32
    s_and_b32 s24, s2, 7
    s_bfe_u32 s25, s2, 0x20003
    s_lshl2_add_u32 s24, s24, s25
    s_lshr_b32 s25, s2, 5
    v_lshrrev_b32 v2, 6, v0
    v_and_b32 v3, 63, v0
    v_lshlrev_b32 v1, 4, v3
    v_readfirstlane_b32 s29, v2
    v_and_b32 v3, 0xf0, v1
    v_mov_b32 v2, 0
    s_lshl_b32 s3, s24, 8
    v_add_u32 v3, s3, v3
    s_lshl_b32 s30, s24, 21
    s_lshl_b32 s31, s25, 18
    s_or_b32 s30, s30, s31
    s_lshl_b32 s31, s29, 13
    s_or_b32 s30, s30, s31
    s_mov_b32 s32, 4096
    s_mov_b32 s18, 0x2000
    s_mov_b32 s19, 0x20000
    s_mov_b32 s22, 0x2000
    s_mov_b32 s23, 0x20000
    s_cmp_eq_u32 s29, 2
    s_cbranch_scc1 L_helper
    s_waitcnt lgkmcnt(0)
    s_add_u32 s16, s6, s30
    s_addc_u32 s17, s7, 0
    global_load_dwordx4 v[4:7], v3, s[4:5]
    s_add_u32 s20, s8, s30
    s_addc_u32 s21, s9, 0
    buffer_load_dwordx4 v[40:43], v1, s[16:19], 0 offen nt
    s_mov_b32 s28, 0x3fb8aa3b
    s_mov_b32 s36, 0x3db504f3
    s_mov_b32 s37, s36
    v_mov_b32 v88, 0
    buffer_load_dwordx4 v[44:47], v1, s[16:19], 0 offen offset:1024 nt
    v_mov_b32 v89, 0
    v_mov_b32 v90, 0
    v_mov_b32 v91, 0
    v_mov_b32 v92, 0
    buffer_load_dwordx4 v[48:51], v1, s[16:19], 0 offen offset:2048 nt
    v_mov_b32 v93, 0
    v_mov_b32 v94, 0
    v_mov_b32 v95, 0
    v_mov_b32 v104, 0xff7fffff
    buffer_load_dwordx4 v[52:55], v1, s[16:19], 0 offen offset:3072 nt
    v_mov_b32 v105, 0
    s_lshl1_add_u32 s33, s25, s29
    s_lshl_b32 s34, s24, 13
    s_lshl_b32 s35, s33, 9
    buffer_load_dwordx4 v[56:59], v1, s[16:19], s32 offen nt
    s_or_b32 s35, s35, s34
    v_and_b32 v119, 0xf0, v1
    v_lshrrev_b32 v116, 8, v1
    v_lshl_add_u32 v115, v119, 1, s35
    buffer_load_dwordx4 v[60:63], v1, s[16:19], s32 offen offset:1024 nt
    v_lshl_add_u32 v115, v116, 3, v115
    s_lshl_b32 s35, s33, 5
    s_or_b32 s34, s34, s35
    v_and_b32 v114, 0x3c0, v1
    buffer_load_dwordx4 v[64:67], v1, s[16:19], s32 offen offset:2048 nt
    v_lshl_add_u32 v114, v114, 3, s34
    v_bfe_u32 v118, v1, 4, 2
    v_lshl_add_u32 v114, v118, 3, v114
    s_add_u32 s34, s3, 0x40000
    buffer_load_dwordx4 v[68:71], v1, s[16:19], s32 offen offset:3072 nt
    v_lshrrev_b32 v119, 1, v119
    v_add_u32 v119, s34, v119
    s_lshl3_add_u32 s34, s33, s34
    v_mov_b32 v118, s34
    s_add_u32 s16, s16, 16384
    s_addc_u32 s17, s17, 0
    buffer_load_dwordx4 v[8:11], v1, s[16:19], 0 offen nt
    s_and_b32 s34, s33, 3
    s_lshl_b32 s34, s34, 6
    s_and_b32 s35, s33, 12
    s_or_b32 s34, s34, s35
    buffer_load_dwordx4 v[12:15], v1, s[16:19], 0 offen offset:1024 nt
    s_or_b32 s34, s34, s3
    v_lshl_add_u32 v116, v116, 4, s34
    s_lshl_b32 s33, s24, 2
    s_add_u32 s12, s12, s33
    s_addc_u32 s13, s13, 0
    s_barrier
    s_waitcnt vmcnt(9)
    buffer_load_dwordx4 v[16:19], v1, s[16:19], 0 offen offset:2048 nt
    buffer_load_dwordx4 v[20:23], v1, s[16:19], 0 offen offset:3072 nt
    v_dot2_f32_bf16 v72, v40, v4, 0
    v_dot2_f32_bf16 v72, v41, v5, v72
    v_dot2_f32_bf16 v72, v42, v6, v72
    v_dot2_f32_bf16 v72, v43, v7, v72
    s_waitcnt vmcnt(10)
    v_dot2_f32_bf16 v73, v44, v4, 0
    s_nop 0
    v_add_f32_dpp v72, v72, v72 row_ror:8 row_mask:0xf bank_mask:0xf
    v_dot2_f32_bf16 v73, v45, v5, v73
    v_dot2_f32_bf16 v73, v46, v6, v73
    v_dot2_f32_bf16 v73, v47, v7, v73
    v_add_f32_dpp v72, v72, v72 row_ror:4 row_mask:0xf bank_mask:0xf
    s_waitcnt vmcnt(9)
    buffer_load_dwordx4 v[24:27], v1, s[16:19], s32 offen nt
    buffer_load_dwordx4 v[28:31], v1, s[16:19], s32 offen offset:1024 nt
    v_dot2_f32_bf16 v74, v48, v4, 0
    v_add_f32_dpp v73, v73, v73 row_ror:8 row_mask:0xf bank_mask:0xf
    v_dot2_f32_bf16 v74, v49, v5, v74
    v_dot2_f32_bf16 v74, v50, v6, v74
    v_dot2_f32_bf16 v74, v51, v7, v74
    v_add_f32_dpp v73, v73, v73 row_ror:4 row_mask:0xf bank_mask:0xf
    v_add_f32_dpp v72, v72, v72 row_ror:2 row_mask:0xf bank_mask:0xf
    s_waitcnt vmcnt(10)
    v_dot2_f32_bf16 v75, v52, v4, 0
    v_add_f32_dpp v74, v74, v74 row_ror:8 row_mask:0xf bank_mask:0xf
    v_dot2_f32_bf16 v75, v53, v5, v75
    v_dot2_f32_bf16 v75, v54, v6, v75
    v_dot2_f32_bf16 v75, v55, v7, v75
    v_add_f32_dpp v74, v74, v74 row_ror:4 row_mask:0xf bank_mask:0xf
    v_add_f32_dpp v73, v73, v73 row_ror:2 row_mask:0xf bank_mask:0xf
    v_add_f32_dpp v72, v72, v72 row_ror:1 row_mask:0xf bank_mask:0xf
    s_waitcnt vmcnt(9)
    buffer_load_dwordx4 v[32:35], v1, s[16:19], s32 offen offset:2048 nt
    buffer_load_dwordx4 v[36:39], v1, s[16:19], s32 offen offset:3072 nt
    v_dot2_f32_bf16 v76, v56, v4, 0
    v_add_f32_dpp v75, v75, v75 row_ror:8 row_mask:0xf bank_mask:0xf
    v_dot2_f32_bf16 v76, v57, v5, v76
    v_dot2_f32_bf16 v76, v58, v6, v76
    v_dot2_f32_bf16 v76, v59, v7, v76
    v_add_f32_dpp v75, v75, v75 row_ror:4 row_mask:0xf bank_mask:0xf
    v_add_f32_dpp v74, v74, v74 row_ror:2 row_mask:0xf bank_mask:0xf
    v_add_f32_dpp v73, v73, v73 row_ror:1 row_mask:0xf bank_mask:0xf
    s_waitcnt vmcnt(10)
    v_dot2_f32_bf16 v77, v60, v4, 0
    v_add_f32_dpp v76, v76, v76 row_ror:8 row_mask:0xf bank_mask:0xf
    v_dot2_f32_bf16 v77, v61, v5, v77
    v_dot2_f32_bf16 v77, v62, v6, v77
    v_dot2_f32_bf16 v77, v63, v7, v77
    v_add_f32_dpp v76, v76, v76 row_ror:4 row_mask:0xf bank_mask:0xf
    v_add_f32_dpp v75, v75, v75 row_ror:2 row_mask:0xf bank_mask:0xf
    v_add_f32_dpp v74, v74, v74 row_ror:1 row_mask:0xf bank_mask:0xf
    v_cvt_pk_bf16_f32 v73, v72, v73
    v_lshlrev_b32 v72, 16, v73
    v_and_b32 v73, 0xffff0000, v73
    v_pk_mul_f32 v[72:73], v[72:73], s[36:37]
    v_cvt_pk_bf16_f32 v73, v72, v73
    v_lshlrev_b32 v72, 16, v73
    v_and_b32 v73, 0xffff0000, v73
    s_waitcnt vmcnt(9)
    buffer_load_dwordx4 v[40:43], v1, s[20:23], 0 offen nt
    buffer_load_dwordx4 v[44:47], v1, s[20:23], 0 offen offset:1024 nt
    v_dot2_f32_bf16 v78, v64, v4, 0
    v_add_f32_dpp v77, v77, v77 row_ror:8 row_mask:0xf bank_mask:0xf
    v_dot2_f32_bf16 v78, v65, v5, v78
    v_dot2_f32_bf16 v78, v66, v6, v78
    v_dot2_f32_bf16 v78, v67, v7, v78
    v_add_f32_dpp v77, v77, v77 row_ror:4 row_mask:0xf bank_mask:0xf
    v_add_f32_dpp v76, v76, v76 row_ror:2 row_mask:0xf bank_mask:0xf
    v_add_f32_dpp v75, v75, v75 row_ror:1 row_mask:0xf bank_mask:0xf
    s_waitcnt vmcnt(10)
    v_dot2_f32_bf16 v79, v68, v4, 0
    v_add_f32_dpp v78, v78, v78 row_ror:8 row_mask:0xf bank_mask:0xf
    v_dot2_f32_bf16 v79, v69, v5, v79
    v_dot2_f32_bf16 v79, v70, v6, v79
    v_dot2_f32_bf16 v79, v71, v7, v79
    v_add_f32_dpp v78, v78, v78 row_ror:4 row_mask:0xf bank_mask:0xf
    v_add_f32_dpp v77, v77, v77 row_ror:2 row_mask:0xf bank_mask:0xf
    v_add_f32_dpp v76, v76, v76 row_ror:1 row_mask:0xf bank_mask:0xf
    v_cvt_pk_bf16_f32 v75, v74, v75
    v_lshlrev_b32 v74, 16, v75
    v_and_b32 v75, 0xffff0000, v75
    v_pk_mul_f32 v[74:75], v[74:75], s[36:37]
    v_cvt_pk_bf16_f32 v75, v74, v75
    v_lshlrev_b32 v74, 16, v75
    v_and_b32 v75, 0xffff0000, v75
    v_add_f32_dpp v79, v79, v79 row_ror:8 row_mask:0xf bank_mask:0xf
    v_add_f32_dpp v78, v78, v78 row_ror:2 row_mask:0xf bank_mask:0xf
    v_add_f32_dpp v77, v77, v77 row_ror:1 row_mask:0xf bank_mask:0xf
    v_add_f32_dpp v79, v79, v79 row_ror:4 row_mask:0xf bank_mask:0xf
    v_max3_f32 v107, v72, v73, v74
    v_add_f32_dpp v78, v78, v78 row_ror:1 row_mask:0xf bank_mask:0xf
    v_add_f32_dpp v79, v79, v79 row_ror:2 row_mask:0xf bank_mask:0xf
    v_cvt_pk_bf16_f32 v77, v76, v77
    v_lshlrev_b32 v76, 16, v77
    v_and_b32 v77, 0xffff0000, v77
    v_pk_mul_f32 v[76:77], v[76:77], s[36:37]
    v_cvt_pk_bf16_f32 v77, v76, v77
    v_lshlrev_b32 v76, 16, v77
    v_and_b32 v77, 0xffff0000, v77
    v_add_f32_dpp v79, v79, v79 row_ror:1 row_mask:0xf bank_mask:0xf
    v_max3_f32 v107, v107, v75, v76
    v_cvt_pk_bf16_f32 v79, v78, v79
    v_lshlrev_b32 v78, 16, v79
    v_and_b32 v79, 0xffff0000, v79
    v_pk_mul_f32 v[78:79], v[78:79], s[36:37]
    v_cvt_pk_bf16_f32 v79, v78, v79
    v_lshlrev_b32 v78, 16, v79
    v_and_b32 v79, 0xffff0000, v79
    v_max3_f32 v107, v107, v77, v78
    v_max_f32 v107, v107, v79
    v_mul_f32 v107, s28, v107
    v_max_f32 v107, v107, v104
    v_sub_f32 v106, v104, v107
    v_mov_b32 v104, v107
    v_exp_f32 v106, v106
    v_fma_f32 v72, v72, s28, -v104
    v_fma_f32 v73, v73, s28, -v104
    v_fma_f32 v74, v74, s28, -v104
    v_fma_f32 v75, v75, s28, -v104
    v_fma_f32 v76, v76, s28, -v104
    v_fma_f32 v77, v77, s28, -v104
    v_fma_f32 v78, v78, s28, -v104
    v_fma_f32 v79, v79, s28, -v104
    v_exp_f32 v80, v72
    v_exp_f32 v81, v73
    v_exp_f32 v82, v74
    v_exp_f32 v83, v75
    v_exp_f32 v84, v76
    v_exp_f32 v85, v77
    v_exp_f32 v86, v78
    v_exp_f32 v87, v79
    v_fma_f32 v105, v105, v106, v80
    v_add_f32 v105, v105, v81
    v_add_f32 v105, v105, v82
    v_add_f32 v105, v105, v83
    v_add_f32 v105, v105, v84
    v_add_f32 v105, v105, v85
    v_add_f32 v105, v105, v86
    v_add_f32 v105, v105, v87
    s_mov_b32 s26, 14
L_loop:
    s_waitcnt vmcnt(9)
    buffer_load_dwordx4 v[48:51], v1, s[20:23], 0 offen offset:2048 nt
    buffer_load_dwordx4 v[52:55], v1, s[20:23], 0 offen offset:3072 nt
    v_dot2_f32_bf16 v72, v8, v4, 0
    v_dot2_f32_bf16 v72, v9, v5, v72
    v_dot2_f32_bf16 v72, v10, v6, v72
    v_dot2_f32_bf16 v72, v11, v7, v72
    s_waitcnt vmcnt(10)
    v_dot2_f32_bf16 v73, v12, v4, 0
    s_nop 0
    v_add_f32_dpp v72, v72, v72 row_ror:8 row_mask:0xf bank_mask:0xf
    v_dot2_f32_bf16 v73, v13, v5, v73
    v_dot2_f32_bf16 v73, v14, v6, v73
    v_dot2_f32_bf16 v73, v15, v7, v73
    v_add_f32_dpp v72, v72, v72 row_ror:4 row_mask:0xf bank_mask:0xf
    s_waitcnt vmcnt(9)
    buffer_load_dwordx4 v[56:59], v1, s[20:23], s32 offen nt
    buffer_load_dwordx4 v[60:63], v1, s[20:23], s32 offen offset:1024 nt
    v_dot2_f32_bf16 v74, v16, v4, 0
    v_add_f32_dpp v73, v73, v73 row_ror:8 row_mask:0xf bank_mask:0xf
    v_dot2_f32_bf16 v74, v17, v5, v74
    v_dot2_f32_bf16 v74, v18, v6, v74
    v_dot2_f32_bf16 v74, v19, v7, v74
    v_add_f32_dpp v73, v73, v73 row_ror:4 row_mask:0xf bank_mask:0xf
    v_add_f32_dpp v72, v72, v72 row_ror:2 row_mask:0xf bank_mask:0xf
    s_waitcnt vmcnt(10)
    v_dot2_f32_bf16 v75, v20, v4, 0
    v_add_f32_dpp v74, v74, v74 row_ror:8 row_mask:0xf bank_mask:0xf
    v_dot2_f32_bf16 v75, v21, v5, v75
    v_dot2_f32_bf16 v75, v22, v6, v75
    v_dot2_f32_bf16 v75, v23, v7, v75
    v_add_f32_dpp v74, v74, v74 row_ror:4 row_mask:0xf bank_mask:0xf
    v_add_f32_dpp v73, v73, v73 row_ror:2 row_mask:0xf bank_mask:0xf
    v_add_f32_dpp v72, v72, v72 row_ror:1 row_mask:0xf bank_mask:0xf
    s_waitcnt vmcnt(9)
    buffer_load_dwordx4 v[64:67], v1, s[20:23], s32 offen offset:2048 nt
    buffer_load_dwordx4 v[68:71], v1, s[20:23], s32 offen offset:3072 nt
    v_dot2_f32_bf16 v76, v24, v4, 0
    v_add_f32_dpp v75, v75, v75 row_ror:8 row_mask:0xf bank_mask:0xf
    v_dot2_f32_bf16 v76, v25, v5, v76
    v_dot2_f32_bf16 v76, v26, v6, v76
    v_dot2_f32_bf16 v76, v27, v7, v76
    v_add_f32_dpp v75, v75, v75 row_ror:4 row_mask:0xf bank_mask:0xf
    v_add_f32_dpp v74, v74, v74 row_ror:2 row_mask:0xf bank_mask:0xf
    v_add_f32_dpp v73, v73, v73 row_ror:1 row_mask:0xf bank_mask:0xf
    s_waitcnt vmcnt(10)
    v_dot2_f32_bf16 v77, v28, v4, 0
    v_add_f32_dpp v76, v76, v76 row_ror:8 row_mask:0xf bank_mask:0xf
    v_dot2_f32_bf16 v77, v29, v5, v77
    v_dot2_f32_bf16 v77, v30, v6, v77
    v_dot2_f32_bf16 v77, v31, v7, v77
    v_add_f32_dpp v76, v76, v76 row_ror:4 row_mask:0xf bank_mask:0xf
    v_add_f32_dpp v75, v75, v75 row_ror:2 row_mask:0xf bank_mask:0xf
    v_add_f32_dpp v74, v74, v74 row_ror:1 row_mask:0xf bank_mask:0xf
    v_cvt_pk_bf16_f32 v73, v72, v73
    v_lshlrev_b32 v72, 16, v73
    v_and_b32 v73, 0xffff0000, v73
    v_pk_mul_f32 v[72:73], v[72:73], s[36:37]
    v_cvt_pk_bf16_f32 v73, v72, v73
    v_lshlrev_b32 v72, 16, v73
    v_and_b32 v73, 0xffff0000, v73
    s_waitcnt vmcnt(9)
    s_add_u32 s16, s16, 16384
    s_addc_u32 s17, s17, 0
    buffer_load_dwordx4 v[8:11], v1, s[16:19], 0 offen nt
    buffer_load_dwordx4 v[12:15], v1, s[16:19], 0 offen offset:1024 nt
    v_dot2_f32_bf16 v78, v32, v4, 0
    v_add_f32_dpp v77, v77, v77 row_ror:8 row_mask:0xf bank_mask:0xf
    v_dot2_f32_bf16 v78, v33, v5, v78
    v_dot2_f32_bf16 v78, v34, v6, v78
    v_dot2_f32_bf16 v78, v35, v7, v78
    v_add_f32_dpp v77, v77, v77 row_ror:4 row_mask:0xf bank_mask:0xf
    v_add_f32_dpp v76, v76, v76 row_ror:2 row_mask:0xf bank_mask:0xf
    v_add_f32_dpp v75, v75, v75 row_ror:1 row_mask:0xf bank_mask:0xf
    s_waitcnt vmcnt(10)
    v_dot2_f32_bf16 v79, v36, v4, 0
    v_add_f32_dpp v78, v78, v78 row_ror:8 row_mask:0xf bank_mask:0xf
    v_dot2_f32_bf16 v79, v37, v5, v79
    v_dot2_f32_bf16 v79, v38, v6, v79
    v_dot2_f32_bf16 v79, v39, v7, v79
    v_add_f32_dpp v78, v78, v78 row_ror:4 row_mask:0xf bank_mask:0xf
    v_add_f32_dpp v77, v77, v77 row_ror:2 row_mask:0xf bank_mask:0xf
    v_add_f32_dpp v76, v76, v76 row_ror:1 row_mask:0xf bank_mask:0xf
    v_cvt_pk_bf16_f32 v75, v74, v75
    v_lshlrev_b32 v74, 16, v75
    v_and_b32 v75, 0xffff0000, v75
    v_pk_mul_f32 v[74:75], v[74:75], s[36:37]
    v_cvt_pk_bf16_f32 v75, v74, v75
    v_lshlrev_b32 v74, 16, v75
    v_and_b32 v75, 0xffff0000, v75
    s_waitcnt vmcnt(9)
    buffer_load_dwordx4 v[16:19], v1, s[16:19], 0 offen offset:2048 nt
    buffer_load_dwordx4 v[20:23], v1, s[16:19], 0 offen offset:3072 nt
    v_lshlrev_b32 v96, 16, v40
    v_and_b32 v97, 0xffff0000, v40
    v_lshlrev_b32 v98, 16, v41
    v_and_b32 v99, 0xffff0000, v41
    v_lshlrev_b32 v100, 16, v42
    v_and_b32 v101, 0xffff0000, v42
    v_lshlrev_b32 v102, 16, v43
    v_and_b32 v103, 0xffff0000, v43
    v_pk_fma_f32 v[88:89], v[96:97], v[80:81], v[88:89] op_sel_hi:[1,0,1]
    v_pk_fma_f32 v[90:91], v[98:99], v[80:81], v[90:91] op_sel_hi:[1,0,1]
    v_pk_fma_f32 v[92:93], v[100:101], v[80:81], v[92:93] op_sel_hi:[1,0,1]
    v_pk_fma_f32 v[94:95], v[102:103], v[80:81], v[94:95] op_sel_hi:[1,0,1]
    v_add_f32_dpp v79, v79, v79 row_ror:8 row_mask:0xf bank_mask:0xf
    v_add_f32_dpp v78, v78, v78 row_ror:2 row_mask:0xf bank_mask:0xf
    v_add_f32_dpp v77, v77, v77 row_ror:1 row_mask:0xf bank_mask:0xf
    v_add_f32_dpp v79, v79, v79 row_ror:4 row_mask:0xf bank_mask:0xf
    v_max3_f32 v107, v72, v73, v74
    s_waitcnt vmcnt(10)
    v_lshlrev_b32 v96, 16, v44
    v_and_b32 v97, 0xffff0000, v44
    v_lshlrev_b32 v98, 16, v45
    v_and_b32 v99, 0xffff0000, v45
    v_lshlrev_b32 v100, 16, v46
    v_and_b32 v101, 0xffff0000, v46
    v_lshlrev_b32 v102, 16, v47
    v_and_b32 v103, 0xffff0000, v47
    v_pk_fma_f32 v[88:89], v[96:97], v[80:81], v[88:89] op_sel:[0,1,0] op_sel_hi:[1,1,1]
    v_pk_fma_f32 v[90:91], v[98:99], v[80:81], v[90:91] op_sel:[0,1,0] op_sel_hi:[1,1,1]
    v_pk_fma_f32 v[92:93], v[100:101], v[80:81], v[92:93] op_sel:[0,1,0] op_sel_hi:[1,1,1]
    v_pk_fma_f32 v[94:95], v[102:103], v[80:81], v[94:95] op_sel:[0,1,0] op_sel_hi:[1,1,1]
    v_add_f32_dpp v78, v78, v78 row_ror:1 row_mask:0xf bank_mask:0xf
    v_add_f32_dpp v79, v79, v79 row_ror:2 row_mask:0xf bank_mask:0xf
    v_cvt_pk_bf16_f32 v77, v76, v77
    v_lshlrev_b32 v76, 16, v77
    v_and_b32 v77, 0xffff0000, v77
    v_pk_mul_f32 v[76:77], v[76:77], s[36:37]
    v_cvt_pk_bf16_f32 v77, v76, v77
    v_lshlrev_b32 v76, 16, v77
    v_and_b32 v77, 0xffff0000, v77
    v_add_f32_dpp v79, v79, v79 row_ror:1 row_mask:0xf bank_mask:0xf
    v_max3_f32 v107, v107, v75, v76
    s_waitcnt vmcnt(9)
    buffer_load_dwordx4 v[24:27], v1, s[16:19], s32 offen nt
    buffer_load_dwordx4 v[28:31], v1, s[16:19], s32 offen offset:1024 nt
    v_lshlrev_b32 v96, 16, v48
    v_and_b32 v97, 0xffff0000, v48
    v_lshlrev_b32 v98, 16, v49
    v_and_b32 v99, 0xffff0000, v49
    v_lshlrev_b32 v100, 16, v50
    v_and_b32 v101, 0xffff0000, v50
    v_lshlrev_b32 v102, 16, v51
    v_and_b32 v103, 0xffff0000, v51
    v_pk_fma_f32 v[88:89], v[96:97], v[82:83], v[88:89] op_sel_hi:[1,0,1]
    v_pk_fma_f32 v[90:91], v[98:99], v[82:83], v[90:91] op_sel_hi:[1,0,1]
    v_pk_fma_f32 v[92:93], v[100:101], v[82:83], v[92:93] op_sel_hi:[1,0,1]
    v_pk_fma_f32 v[94:95], v[102:103], v[82:83], v[94:95] op_sel_hi:[1,0,1]
    v_cvt_pk_bf16_f32 v79, v78, v79
    v_lshlrev_b32 v78, 16, v79
    v_and_b32 v79, 0xffff0000, v79
    v_pk_mul_f32 v[78:79], v[78:79], s[36:37]
    v_cvt_pk_bf16_f32 v79, v78, v79
    v_lshlrev_b32 v78, 16, v79
    v_and_b32 v79, 0xffff0000, v79
    v_max3_f32 v107, v107, v77, v78
    v_max_f32 v107, v107, v79
    v_mul_f32 v107, s28, v107
    v_max_f32 v107, v107, v104
    v_sub_f32 v106, v104, v107
    v_mov_b32 v104, v107
    v_exp_f32 v106, v106
    s_waitcnt vmcnt(10)
    v_lshlrev_b32 v96, 16, v52
    v_and_b32 v97, 0xffff0000, v52
    v_lshlrev_b32 v98, 16, v53
    v_and_b32 v99, 0xffff0000, v53
    v_lshlrev_b32 v100, 16, v54
    v_and_b32 v101, 0xffff0000, v54
    v_lshlrev_b32 v102, 16, v55
    v_and_b32 v103, 0xffff0000, v55
    v_pk_fma_f32 v[88:89], v[96:97], v[82:83], v[88:89] op_sel:[0,1,0] op_sel_hi:[1,1,1]
    v_pk_fma_f32 v[90:91], v[98:99], v[82:83], v[90:91] op_sel:[0,1,0] op_sel_hi:[1,1,1]
    v_pk_fma_f32 v[92:93], v[100:101], v[82:83], v[92:93] op_sel:[0,1,0] op_sel_hi:[1,1,1]
    v_pk_fma_f32 v[94:95], v[102:103], v[82:83], v[94:95] op_sel:[0,1,0] op_sel_hi:[1,1,1]
    v_fma_f32 v72, v72, s28, -v104
    v_fma_f32 v73, v73, s28, -v104
    v_fma_f32 v74, v74, s28, -v104
    v_fma_f32 v75, v75, s28, -v104
    v_fma_f32 v76, v76, s28, -v104
    v_fma_f32 v77, v77, s28, -v104
    v_fma_f32 v78, v78, s28, -v104
    v_fma_f32 v79, v79, s28, -v104
    v_exp_f32 v80, v72
    v_exp_f32 v81, v73
    s_waitcnt vmcnt(9)
    buffer_load_dwordx4 v[32:35], v1, s[16:19], s32 offen offset:2048 nt
    buffer_load_dwordx4 v[36:39], v1, s[16:19], s32 offen offset:3072 nt
    v_lshlrev_b32 v96, 16, v56
    v_and_b32 v97, 0xffff0000, v56
    v_lshlrev_b32 v98, 16, v57
    v_and_b32 v99, 0xffff0000, v57
    v_lshlrev_b32 v100, 16, v58
    v_and_b32 v101, 0xffff0000, v58
    v_lshlrev_b32 v102, 16, v59
    v_and_b32 v103, 0xffff0000, v59
    v_pk_fma_f32 v[88:89], v[96:97], v[84:85], v[88:89] op_sel_hi:[1,0,1]
    v_pk_fma_f32 v[90:91], v[98:99], v[84:85], v[90:91] op_sel_hi:[1,0,1]
    v_pk_fma_f32 v[92:93], v[100:101], v[84:85], v[92:93] op_sel_hi:[1,0,1]
    v_pk_fma_f32 v[94:95], v[102:103], v[84:85], v[94:95] op_sel_hi:[1,0,1]
    v_exp_f32 v82, v74
    v_exp_f32 v83, v75
    v_fma_f32 v105, v105, v106, v80
    v_add_f32 v105, v105, v81
    s_waitcnt vmcnt(10)
    v_lshlrev_b32 v96, 16, v60
    v_and_b32 v97, 0xffff0000, v60
    v_lshlrev_b32 v98, 16, v61
    v_and_b32 v99, 0xffff0000, v61
    v_lshlrev_b32 v100, 16, v62
    v_and_b32 v101, 0xffff0000, v62
    v_lshlrev_b32 v102, 16, v63
    v_and_b32 v103, 0xffff0000, v63
    v_pk_fma_f32 v[88:89], v[96:97], v[84:85], v[88:89] op_sel:[0,1,0] op_sel_hi:[1,1,1]
    v_pk_fma_f32 v[90:91], v[98:99], v[84:85], v[90:91] op_sel:[0,1,0] op_sel_hi:[1,1,1]
    v_pk_fma_f32 v[92:93], v[100:101], v[84:85], v[92:93] op_sel:[0,1,0] op_sel_hi:[1,1,1]
    v_pk_fma_f32 v[94:95], v[102:103], v[84:85], v[94:95] op_sel:[0,1,0] op_sel_hi:[1,1,1]
    v_exp_f32 v84, v76
    v_exp_f32 v85, v77
    v_add_f32 v105, v105, v82
    v_add_f32 v105, v105, v83
    s_waitcnt vmcnt(9)
    s_add_u32 s20, s20, 16384
    s_addc_u32 s21, s21, 0
    buffer_load_dwordx4 v[40:43], v1, s[20:23], 0 offen nt
    buffer_load_dwordx4 v[44:47], v1, s[20:23], 0 offen offset:1024 nt
    v_lshlrev_b32 v96, 16, v64
    v_and_b32 v97, 0xffff0000, v64
    v_lshlrev_b32 v98, 16, v65
    v_and_b32 v99, 0xffff0000, v65
    v_lshlrev_b32 v100, 16, v66
    v_and_b32 v101, 0xffff0000, v66
    v_lshlrev_b32 v102, 16, v67
    v_and_b32 v103, 0xffff0000, v67
    v_pk_fma_f32 v[88:89], v[96:97], v[86:87], v[88:89] op_sel_hi:[1,0,1]
    v_pk_fma_f32 v[90:91], v[98:99], v[86:87], v[90:91] op_sel_hi:[1,0,1]
    v_pk_fma_f32 v[92:93], v[100:101], v[86:87], v[92:93] op_sel_hi:[1,0,1]
    v_pk_fma_f32 v[94:95], v[102:103], v[86:87], v[94:95] op_sel_hi:[1,0,1]
    v_exp_f32 v86, v78
    v_add_f32 v105, v105, v84
    v_add_f32 v105, v105, v85
    s_waitcnt vmcnt(10)
    v_lshlrev_b32 v96, 16, v68
    v_and_b32 v97, 0xffff0000, v68
    v_lshlrev_b32 v98, 16, v69
    v_and_b32 v99, 0xffff0000, v69
    v_lshlrev_b32 v100, 16, v70
    v_and_b32 v101, 0xffff0000, v70
    v_lshlrev_b32 v102, 16, v71
    v_and_b32 v103, 0xffff0000, v71
    v_pk_fma_f32 v[88:89], v[96:97], v[86:87], v[88:89] op_sel:[0,1,0] op_sel_hi:[1,1,1]
    v_pk_fma_f32 v[90:91], v[98:99], v[86:87], v[90:91] op_sel:[0,1,0] op_sel_hi:[1,1,1]
    v_pk_fma_f32 v[92:93], v[100:101], v[86:87], v[92:93] op_sel:[0,1,0] op_sel_hi:[1,1,1]
    v_pk_fma_f32 v[94:95], v[102:103], v[86:87], v[94:95] op_sel:[0,1,0] op_sel_hi:[1,1,1]
    v_exp_f32 v87, v79
    v_pk_mul_f32 v[88:89], v[88:89], v[106:107] op_sel_hi:[1,0]
    v_pk_mul_f32 v[90:91], v[90:91], v[106:107] op_sel_hi:[1,0]
    v_pk_mul_f32 v[92:93], v[92:93], v[106:107] op_sel_hi:[1,0]
    v_pk_mul_f32 v[94:95], v[94:95], v[106:107] op_sel_hi:[1,0]
    v_add_f32 v105, v105, v86
    v_add_f32 v105, v105, v87
    s_sub_u32 s26, s26, 1
    s_cmp_lg_u32 s26, 0
    s_cbranch_scc1 L_loop
    s_branch L_fin
.p2align 12
L_helper:
    ds_write_b32 v2, v2
    s_lshl_b32 s30, s24, 13
    s_lshl_b32 s31, s25, 10
    s_or_b32 s30, s30, s31
    v_or_b32 v8, s30, v1
    s_add_u32 s30, s3, 0x40000
    v_lshrrev_b32 v9, 2, v1
    v_add_u32 v27, s30, v9
    s_add_u32 s30, s30, 128
    v_and_b32 v9, 28, v9
    v_add_u32 v9, s30, v9
    s_lshl2_add_u32 s30, s25, s30
    v_mov_b32 v10, s30
    s_lshl_b32 s30, s24, 2
    v_mov_b32 v11, s30
    s_getreg_b32 s33, hwreg(HW_REG_XCC_ID, 0, 4)
    s_add_u32 s33, s33, 1
    v_mov_b32 v12, -1
    v_mov_b32 v13, -1
    v_mov_b32 v14, -1
    v_mov_b32 v15, -1
    s_waitcnt lgkmcnt(0)
    s_barrier
    global_load_dwordx4 v[16:19], v8, s[14:15] sc1
    global_load_dword v24, v27, s[14:15] sc1
    global_load_dword v25, v11, s[12:13] sc1
    s_mov_b32 s34, 32
    s_mov_b32 s35, 2
    s_waitcnt vmcnt(0)
    global_store_dwordx4 v8, v[12:15], s[14:15]
    s_cmp_eq_u32 s25, 0
    s_cbranch_scc1 L_leader
L_wflag:
    global_load_dword v25, v11, s[12:13] sc1
    s_sub_u32 s34, s34, 1
    s_waitcnt vmcnt(0)
    v_readfirstlane_b32 s30, v25
    s_nop 0
    s_cmp_eq_u32 s30, s33
    s_cbranch_scc1 L_hello
    s_cmp_lg_u32 s34, 0
    s_cbranch_scc1 L_wflag
    s_branch L_hdone
L_hello:
    v_mov_b32 v26, 1
    s_mov_b64 exec, 1
    global_store_dword v10, v26, s[14:15]
    s_mov_b32 s34, 0
L_wdec:
    global_load_dword v24, v9, s[14:15] sc1
    s_waitcnt vmcnt(0)
    v_readfirstlane_b32 s35, v24
    s_nop 0
    s_cmp_lg_u32 s35, 0
    s_cbranch_scc1 L_hdone
    s_add_u32 s34, s34, 0x10000
    s_cbranch_scc0 L_wdec
    s_mov_b32 s35, 2
    s_branch L_hdone
L_leader:
    s_mov_b32 exec_hi, 0
    global_store_dword v27, v12, s[14:15]
    s_mov_b64 exec, 0xff
    global_store_dword v9, v2, s[14:15]
    v_mov_b32 v25, s33
    s_mov_b64 exec, 1
    s_waitcnt vmcnt(0)
    global_store_dword v11, v25, s[12:13]
    s_mov_b64 exec, 0xfe
L_whello:
    global_load_dword v24, v9, s[14:15] sc1
    s_sub_u32 s34, s34, 1
    s_waitcnt vmcnt(0)
    v_cmp_ne_u32 vcc, 1, v24
    s_cbranch_vccz L_allin
    s_cmp_lg_u32 s34, 0
    s_cbranch_scc1 L_whello
    s_branch L_decide
L_allin:
    s_mov_b32 s35, 1
L_decide:
    s_mov_b64 exec, 1
    v_mov_b32 v26, s35
    global_store_dword v10, v26, s[14:15]
    global_store_dword v11, v2, s[12:13]
L_hdone:
    s_mov_b64 exec, 1
    v_mov_b32 v24, s35
    s_waitcnt vmcnt(0)
    ds_write_b32 v2, v24
    s_waitcnt lgkmcnt(0)
    s_endpgm
L_fin:
    ds_read_b32 v117, v2
    s_waitcnt vmcnt(9)
    buffer_load_dwordx4 v[48:51], v1, s[20:23], 0 offen offset:2048 nt
    buffer_load_dwordx4 v[52:55], v1, s[20:23], 0 offen offset:3072 nt
    v_dot2_f32_bf16 v72, v8, v4, 0
    v_dot2_f32_bf16 v72, v9, v5, v72
    v_dot2_f32_bf16 v72, v10, v6, v72
    v_dot2_f32_bf16 v72, v11, v7, v72
    s_waitcnt vmcnt(10)
    v_dot2_f32_bf16 v73, v12, v4, 0
    s_nop 0
    v_add_f32_dpp v72, v72, v72 row_ror:8 row_mask:0xf bank_mask:0xf
    v_dot2_f32_bf16 v73, v13, v5, v73
    v_dot2_f32_bf16 v73, v14, v6, v73
    v_dot2_f32_bf16 v73, v15, v7, v73
    v_add_f32_dpp v72, v72, v72 row_ror:4 row_mask:0xf bank_mask:0xf
    s_waitcnt vmcnt(9)
    buffer_load_dwordx4 v[56:59], v1, s[20:23], s32 offen nt
    buffer_load_dwordx4 v[60:63], v1, s[20:23], s32 offen offset:1024 nt
    v_dot2_f32_bf16 v74, v16, v4, 0
    v_add_f32_dpp v73, v73, v73 row_ror:8 row_mask:0xf bank_mask:0xf
    v_dot2_f32_bf16 v74, v17, v5, v74
    v_dot2_f32_bf16 v74, v18, v6, v74
    v_dot2_f32_bf16 v74, v19, v7, v74
    v_add_f32_dpp v73, v73, v73 row_ror:4 row_mask:0xf bank_mask:0xf
    v_add_f32_dpp v72, v72, v72 row_ror:2 row_mask:0xf bank_mask:0xf
    s_waitcnt vmcnt(10)
    v_dot2_f32_bf16 v75, v20, v4, 0
    v_add_f32_dpp v74, v74, v74 row_ror:8 row_mask:0xf bank_mask:0xf
    v_dot2_f32_bf16 v75, v21, v5, v75
    v_dot2_f32_bf16 v75, v22, v6, v75
    v_dot2_f32_bf16 v75, v23, v7, v75
    v_add_f32_dpp v74, v74, v74 row_ror:4 row_mask:0xf bank_mask:0xf
    v_add_f32_dpp v73, v73, v73 row_ror:2 row_mask:0xf bank_mask:0xf
    v_add_f32_dpp v72, v72, v72 row_ror:1 row_mask:0xf bank_mask:0xf
    s_waitcnt vmcnt(9)
    buffer_load_dwordx4 v[64:67], v1, s[20:23], s32 offen offset:2048 nt
    buffer_load_dwordx4 v[68:71], v1, s[20:23], s32 offen offset:3072 nt
    v_dot2_f32_bf16 v76, v24, v4, 0
    v_add_f32_dpp v75, v75, v75 row_ror:8 row_mask:0xf bank_mask:0xf
    v_dot2_f32_bf16 v76, v25, v5, v76
    v_dot2_f32_bf16 v76, v26, v6, v76
    v_dot2_f32_bf16 v76, v27, v7, v76
    v_add_f32_dpp v75, v75, v75 row_ror:4 row_mask:0xf bank_mask:0xf
    v_add_f32_dpp v74, v74, v74 row_ror:2 row_mask:0xf bank_mask:0xf
    v_add_f32_dpp v73, v73, v73 row_ror:1 row_mask:0xf bank_mask:0xf
    s_waitcnt vmcnt(10)
    v_dot2_f32_bf16 v77, v28, v4, 0
    v_add_f32_dpp v76, v76, v76 row_ror:8 row_mask:0xf bank_mask:0xf
    v_dot2_f32_bf16 v77, v29, v5, v77
    v_dot2_f32_bf16 v77, v30, v6, v77
    v_dot2_f32_bf16 v77, v31, v7, v77
    v_add_f32_dpp v76, v76, v76 row_ror:4 row_mask:0xf bank_mask:0xf
    v_add_f32_dpp v75, v75, v75 row_ror:2 row_mask:0xf bank_mask:0xf
    v_add_f32_dpp v74, v74, v74 row_ror:1 row_mask:0xf bank_mask:0xf
    v_cvt_pk_bf16_f32 v73, v72, v73
    v_lshlrev_b32 v72, 16, v73
    v_and_b32 v73, 0xffff0000, v73
    v_pk_mul_f32 v[72:73], v[72:73], s[36:37]
    v_cvt_pk_bf16_f32 v73, v72, v73
    v_lshlrev_b32 v72, 16, v73
    v_and_b32 v73, 0xffff0000, v73
    s_waitcnt vmcnt(9)
    s_add_u32 s20, s20, 16384
    s_addc_u32 s21, s21, 0
    buffer_load_dwordx4 v[8:11], v1, s[20:23], 0 offen nt
    buffer_load_dwordx4 v[12:15], v1, s[20:23], 0 offen offset:1024 nt
    v_dot2_f32_bf16 v78, v32, v4, 0
    v_add_f32_dpp v77, v77, v77 row_ror:8 row_mask:0xf bank_mask:0xf
    v_dot2_f32_bf16 v78, v33, v5, v78
    v_dot2_f32_bf16 v78, v34, v6, v78
    v_dot2_f32_bf16 v78, v35, v7, v78
    v_add_f32_dpp v77, v77, v77 row_ror:4 row_mask:0xf bank_mask:0xf
    v_add_f32_dpp v76, v76, v76 row_ror:2 row_mask:0xf bank_mask:0xf
    v_add_f32_dpp v75, v75, v75 row_ror:1 row_mask:0xf bank_mask:0xf
    s_waitcnt vmcnt(10)
    v_dot2_f32_bf16 v79, v36, v4, 0
    v_add_f32_dpp v78, v78, v78 row_ror:8 row_mask:0xf bank_mask:0xf
    v_dot2_f32_bf16 v79, v37, v5, v79
    v_dot2_f32_bf16 v79, v38, v6, v79
    v_dot2_f32_bf16 v79, v39, v7, v79
    v_add_f32_dpp v78, v78, v78 row_ror:4 row_mask:0xf bank_mask:0xf
    v_add_f32_dpp v77, v77, v77 row_ror:2 row_mask:0xf bank_mask:0xf
    v_add_f32_dpp v76, v76, v76 row_ror:1 row_mask:0xf bank_mask:0xf
    v_cvt_pk_bf16_f32 v75, v74, v75
    v_lshlrev_b32 v74, 16, v75
    v_and_b32 v75, 0xffff0000, v75
    v_pk_mul_f32 v[74:75], v[74:75], s[36:37]
    v_cvt_pk_bf16_f32 v75, v74, v75
    v_lshlrev_b32 v74, 16, v75
    v_and_b32 v75, 0xffff0000, v75
    s_waitcnt vmcnt(9)
    buffer_load_dwordx4 v[16:19], v1, s[20:23], 0 offen offset:2048 nt
    buffer_load_dwordx4 v[20:23], v1, s[20:23], 0 offen offset:3072 nt
    buffer_load_dwordx4 v[24:27], v1, s[20:23], s32 offen nt
    buffer_load_dwordx4 v[28:31], v1, s[20:23], s32 offen offset:1024 nt
    buffer_load_dwordx4 v[32:35], v1, s[20:23], s32 offen offset:2048 nt
    buffer_load_dwordx4 v[36:39], v1, s[20:23], s32 offen offset:3072 nt
    v_lshlrev_b32 v96, 16, v40
    v_and_b32 v97, 0xffff0000, v40
    v_lshlrev_b32 v98, 16, v41
    v_and_b32 v99, 0xffff0000, v41
    v_lshlrev_b32 v100, 16, v42
    v_and_b32 v101, 0xffff0000, v42
    v_lshlrev_b32 v102, 16, v43
    v_and_b32 v103, 0xffff0000, v43
    v_pk_fma_f32 v[88:89], v[96:97], v[80:81], v[88:89] op_sel_hi:[1,0,1]
    v_pk_fma_f32 v[90:91], v[98:99], v[80:81], v[90:91] op_sel_hi:[1,0,1]
    v_pk_fma_f32 v[92:93], v[100:101], v[80:81], v[92:93] op_sel_hi:[1,0,1]
    v_pk_fma_f32 v[94:95], v[102:103], v[80:81], v[94:95] op_sel_hi:[1,0,1]
    v_add_f32_dpp v79, v79, v79 row_ror:8 row_mask:0xf bank_mask:0xf
    v_add_f32_dpp v78, v78, v78 row_ror:2 row_mask:0xf bank_mask:0xf
    v_add_f32_dpp v77, v77, v77 row_ror:1 row_mask:0xf bank_mask:0xf
    v_add_f32_dpp v79, v79, v79 row_ror:4 row_mask:0xf bank_mask:0xf
    v_max3_f32 v107, v72, v73, v74
    s_waitcnt vmcnt(14)
    v_lshlrev_b32 v96, 16, v44
    v_and_b32 v97, 0xffff0000, v44
    v_lshlrev_b32 v98, 16, v45
    v_and_b32 v99, 0xffff0000, v45
    v_lshlrev_b32 v100, 16, v46
    v_and_b32 v101, 0xffff0000, v46
    v_lshlrev_b32 v102, 16, v47
    v_and_b32 v103, 0xffff0000, v47
    v_pk_fma_f32 v[88:89], v[96:97], v[80:81], v[88:89] op_sel:[0,1,0] op_sel_hi:[1,1,1]
    v_pk_fma_f32 v[90:91], v[98:99], v[80:81], v[90:91] op_sel:[0,1,0] op_sel_hi:[1,1,1]
    v_pk_fma_f32 v[92:93], v[100:101], v[80:81], v[92:93] op_sel:[0,1,0] op_sel_hi:[1,1,1]
    v_pk_fma_f32 v[94:95], v[102:103], v[80:81], v[94:95] op_sel:[0,1,0] op_sel_hi:[1,1,1]
    v_add_f32_dpp v78, v78, v78 row_ror:1 row_mask:0xf bank_mask:0xf
    v_add_f32_dpp v79, v79, v79 row_ror:2 row_mask:0xf bank_mask:0xf
    v_cvt_pk_bf16_f32 v77, v76, v77
    v_lshlrev_b32 v76, 16, v77
    v_and_b32 v77, 0xffff0000, v77
    v_pk_mul_f32 v[76:77], v[76:77], s[36:37]
    v_cvt_pk_bf16_f32 v77, v76, v77
    v_lshlrev_b32 v76, 16, v77
    v_and_b32 v77, 0xffff0000, v77
    v_add_f32_dpp v79, v79, v79 row_ror:1 row_mask:0xf bank_mask:0xf
    v_max3_f32 v107, v107, v75, v76
    s_waitcnt vmcnt(13)
    v_lshlrev_b32 v96, 16, v48
    v_and_b32 v97, 0xffff0000, v48
    v_lshlrev_b32 v98, 16, v49
    v_and_b32 v99, 0xffff0000, v49
    v_lshlrev_b32 v100, 16, v50
    v_and_b32 v101, 0xffff0000, v50
    v_lshlrev_b32 v102, 16, v51
    v_and_b32 v103, 0xffff0000, v51
    v_pk_fma_f32 v[88:89], v[96:97], v[82:83], v[88:89] op_sel_hi:[1,0,1]
    v_pk_fma_f32 v[90:91], v[98:99], v[82:83], v[90:91] op_sel_hi:[1,0,1]
    v_pk_fma_f32 v[92:93], v[100:101], v[82:83], v[92:93] op_sel_hi:[1,0,1]
    v_pk_fma_f32 v[94:95], v[102:103], v[82:83], v[94:95] op_sel_hi:[1,0,1]
    v_cvt_pk_bf16_f32 v79, v78, v79
    v_lshlrev_b32 v78, 16, v79
    v_and_b32 v79, 0xffff0000, v79
    v_pk_mul_f32 v[78:79], v[78:79], s[36:37]
    v_cvt_pk_bf16_f32 v79, v78, v79
    v_lshlrev_b32 v78, 16, v79
    v_and_b32 v79, 0xffff0000, v79
    v_max3_f32 v107, v107, v77, v78
    v_max_f32 v107, v107, v79
    v_mul_f32 v107, s28, v107
    v_max_f32 v107, v107, v104
    v_mov_b32 v106, v107
    s_nop 1
    v_permlane32_swap_b32 v106, v107
    v_max_f32 v107, v106, v107
    v_mov_b32 v106, v107
    s_nop 1
    v_permlane16_swap_b32 v106, v107
    v_max_f32 v107, v106, v107
    v_sub_f32 v106, v104, v107
    v_mov_b32 v104, v107
    v_exp_f32 v106, v106
    s_waitcnt vmcnt(12)
    v_lshlrev_b32 v96, 16, v52
    v_and_b32 v97, 0xffff0000, v52
    v_lshlrev_b32 v98, 16, v53
    v_and_b32 v99, 0xffff0000, v53
    v_lshlrev_b32 v100, 16, v54
    v_and_b32 v101, 0xffff0000, v54
    v_lshlrev_b32 v102, 16, v55
    v_and_b32 v103, 0xffff0000, v55
    v_pk_fma_f32 v[88:89], v[96:97], v[82:83], v[88:89] op_sel:[0,1,0] op_sel_hi:[1,1,1]
    v_pk_fma_f32 v[90:91], v[98:99], v[82:83], v[90:91] op_sel:[0,1,0] op_sel_hi:[1,1,1]
    v_pk_fma_f32 v[92:93], v[100:101], v[82:83], v[92:93] op_sel:[0,1,0] op_sel_hi:[1,1,1]
    v_pk_fma_f32 v[94:95], v[102:103], v[82:83], v[94:95] op_sel:[0,1,0] op_sel_hi:[1,1,1]
    v_fma_f32 v72, v72, s28, -v104
    v_fma_f32 v73, v73, s28, -v104
    v_fma_f32 v74, v74, s28, -v104
    v_fma_f32 v75, v75, s28, -v104
    v_fma_f32 v76, v76, s28, -v104
    v_fma_f32 v77, v77, s28, -v104
    v_fma_f32 v78, v78, s28, -v104
    v_fma_f32 v79, v79, s28, -v104
    v_exp_f32 v72, v72
    v_exp_f32 v73, v73
    v_exp_f32 v74, v74
    s_waitcnt vmcnt(11)
    v_lshlrev_b32 v96, 16, v56
    v_and_b32 v97, 0xffff0000, v56
    v_lshlrev_b32 v98, 16, v57
    v_and_b32 v99, 0xffff0000, v57
    v_lshlrev_b32 v100, 16, v58
    v_and_b32 v101, 0xffff0000, v58
    v_lshlrev_b32 v102, 16, v59
    v_and_b32 v103, 0xffff0000, v59
    v_pk_fma_f32 v[88:89], v[96:97], v[84:85], v[88:89] op_sel_hi:[1,0,1]
    v_pk_fma_f32 v[90:91], v[98:99], v[84:85], v[90:91] op_sel_hi:[1,0,1]
    v_pk_fma_f32 v[92:93], v[100:101], v[84:85], v[92:93] op_sel_hi:[1,0,1]
    v_pk_fma_f32 v[94:95], v[102:103], v[84:85], v[94:95] op_sel_hi:[1,0,1]
    v_exp_f32 v75, v75
    v_exp_f32 v76, v76
    v_exp_f32 v77, v77
    v_exp_f32 v78, v78
    v_exp_f32 v79, v79
    s_waitcnt vmcnt(10)
    v_lshlrev_b32 v96, 16, v60
    v_and_b32 v97, 0xffff0000, v60
    v_lshlrev_b32 v98, 16, v61
    v_and_b32 v99, 0xffff0000, v61
    v_lshlrev_b32 v100, 16, v62
    v_and_b32 v101, 0xffff0000, v62
    v_lshlrev_b32 v102, 16, v63
    v_and_b32 v103, 0xffff0000, v63
    v_pk_fma_f32 v[88:89], v[96:97], v[84:85], v[88:89] op_sel:[0,1,0] op_sel_hi:[1,1,1]
    v_pk_fma_f32 v[90:91], v[98:99], v[84:85], v[90:91] op_sel:[0,1,0] op_sel_hi:[1,1,1]
    v_pk_fma_f32 v[92:93], v[100:101], v[84:85], v[92:93] op_sel:[0,1,0] op_sel_hi:[1,1,1]
    v_pk_fma_f32 v[94:95], v[102:103], v[84:85], v[94:95] op_sel:[0,1,0] op_sel_hi:[1,1,1]
    v_fma_f32 v105, v105, v106, v72
    v_add_f32 v105, v105, v73
    v_add_f32 v105, v105, v74
    v_add_f32 v105, v105, v75
    v_add_f32 v105, v105, v76
    v_add_f32 v105, v105, v77
    v_add_f32 v105, v105, v78
    v_add_f32 v105, v105, v79
    v_mov_b32 v107, v105
    s_nop 1
    v_permlane32_swap_b32 v107, v105
    v_add_f32 v105, v107, v105
    v_mov_b32 v107, v105
    s_nop 1
    v_permlane16_swap_b32 v107, v105
    v_add_f32 v105, v107, v105
    s_waitcnt vmcnt(9)
    v_lshlrev_b32 v96, 16, v64
    v_and_b32 v97, 0xffff0000, v64
    v_lshlrev_b32 v98, 16, v65
    v_and_b32 v99, 0xffff0000, v65
    v_lshlrev_b32 v100, 16, v66
    v_and_b32 v101, 0xffff0000, v66
    v_lshlrev_b32 v102, 16, v67
    v_and_b32 v103, 0xffff0000, v67
    v_pk_fma_f32 v[88:89], v[96:97], v[86:87], v[88:89] op_sel_hi:[1,0,1]
    v_pk_fma_f32 v[90:91], v[98:99], v[86:87], v[90:91] op_sel_hi:[1,0,1]
    v_pk_fma_f32 v[92:93], v[100:101], v[86:87], v[92:93] op_sel_hi:[1,0,1]
    v_pk_fma_f32 v[94:95], v[102:103], v[86:87], v[94:95] op_sel_hi:[1,0,1]
L_mode:
    s_waitcnt lgkmcnt(0)
    v_readfirstlane_b32 s27, v117
    s_nop 0
    s_cmp_eq_u32 s27, 0
    s_cbranch_scc1 L_modewait
    s_cmp_lg_u32 s27, 1
    s_mov_b64 exec, 1
    s_cbranch_scc1 L_farml
    global_store_dwordx2 v118, v[104:105], s[14:15]
L_mlback:
    s_mov_b64 exec, -1
    s_waitcnt vmcnt(9)
    v_lshlrev_b32 v96, 16, v68
    v_and_b32 v97, 0xffff0000, v68
    v_lshlrev_b32 v98, 16, v69
    v_and_b32 v99, 0xffff0000, v69
    v_lshlrev_b32 v100, 16, v70
    v_and_b32 v101, 0xffff0000, v70
    v_lshlrev_b32 v102, 16, v71
    v_and_b32 v103, 0xffff0000, v71
    v_pk_fma_f32 v[88:89], v[96:97], v[86:87], v[88:89] op_sel:[0,1,0] op_sel_hi:[1,1,1]
    v_pk_fma_f32 v[90:91], v[98:99], v[86:87], v[90:91] op_sel:[0,1,0] op_sel_hi:[1,1,1]
    v_pk_fma_f32 v[92:93], v[100:101], v[86:87], v[92:93] op_sel:[0,1,0] op_sel_hi:[1,1,1]
    v_pk_fma_f32 v[94:95], v[102:103], v[86:87], v[94:95] op_sel:[0,1,0] op_sel_hi:[1,1,1]
    v_pk_mul_f32 v[88:89], v[88:89], v[106:107] op_sel_hi:[1,0]
    v_pk_mul_f32 v[90:91], v[90:91], v[106:107] op_sel_hi:[1,0]
    v_pk_mul_f32 v[92:93], v[92:93], v[106:107] op_sel_hi:[1,0]
    v_pk_mul_f32 v[94:95], v[94:95], v[106:107] op_sel_hi:[1,0]
    s_waitcnt vmcnt(8)
    v_lshlrev_b32 v96, 16, v8
    v_and_b32 v97, 0xffff0000, v8
    v_lshlrev_b32 v98, 16, v9
    v_and_b32 v99, 0xffff0000, v9
    v_lshlrev_b32 v100, 16, v10
    v_and_b32 v101, 0xffff0000, v10
    v_lshlrev_b32 v102, 16, v11
    v_and_b32 v103, 0xffff0000, v11
    v_pk_fma_f32 v[88:89], v[96:97], v[72:73], v[88:89] op_sel_hi:[1,0,1]
    v_pk_fma_f32 v[90:91], v[98:99], v[72:73], v[90:91] op_sel_hi:[1,0,1]
    v_pk_fma_f32 v[92:93], v[100:101], v[72:73], v[92:93] op_sel_hi:[1,0,1]
    v_pk_fma_f32 v[94:95], v[102:103], v[72:73], v[94:95] op_sel_hi:[1,0,1]
    s_waitcnt vmcnt(7)
    v_lshlrev_b32 v96, 16, v12
    v_and_b32 v97, 0xffff0000, v12
    v_lshlrev_b32 v98, 16, v13
    v_and_b32 v99, 0xffff0000, v13
    v_lshlrev_b32 v100, 16, v14
    v_and_b32 v101, 0xffff0000, v14
    v_lshlrev_b32 v102, 16, v15
    v_and_b32 v103, 0xffff0000, v15
    v_pk_fma_f32 v[88:89], v[96:97], v[72:73], v[88:89] op_sel:[0,1,0] op_sel_hi:[1,1,1]
    v_pk_fma_f32 v[90:91], v[98:99], v[72:73], v[90:91] op_sel:[0,1,0] op_sel_hi:[1,1,1]
    v_pk_fma_f32 v[92:93], v[100:101], v[72:73], v[92:93] op_sel:[0,1,0] op_sel_hi:[1,1,1]
    v_pk_fma_f32 v[94:95], v[102:103], v[72:73], v[94:95] op_sel:[0,1,0] op_sel_hi:[1,1,1]
    s_waitcnt vmcnt(6)
    v_lshlrev_b32 v96, 16, v16
    v_and_b32 v97, 0xffff0000, v16
    v_lshlrev_b32 v98, 16, v17
    v_and_b32 v99, 0xffff0000, v17
    v_lshlrev_b32 v100, 16, v18
    v_and_b32 v101, 0xffff0000, v18
    v_lshlrev_b32 v102, 16, v19
    v_and_b32 v103, 0xffff0000, v19
    v_pk_fma_f32 v[88:89], v[96:97], v[74:75], v[88:89] op_sel_hi:[1,0,1]
    v_pk_fma_f32 v[90:91], v[98:99], v[74:75], v[90:91] op_sel_hi:[1,0,1]
    v_pk_fma_f32 v[92:93], v[100:101], v[74:75], v[92:93] op_sel_hi:[1,0,1]
    v_pk_fma_f32 v[94:95], v[102:103], v[74:75], v[94:95] op_sel_hi:[1,0,1]
    s_waitcnt vmcnt(5)
    v_lshlrev_b32 v96, 16, v20
    v_and_b32 v97, 0xffff0000, v20
    v_lshlrev_b32 v98, 16, v21
    v_and_b32 v99, 0xffff0000, v21
    v_lshlrev_b32 v100, 16, v22
    v_and_b32 v101, 0xffff0000, v22
    v_lshlrev_b32 v102, 16, v23
    v_and_b32 v103, 0xffff0000, v23
    v_pk_fma_f32 v[88:89], v[96:97], v[74:75], v[88:89] op_sel:[0,1,0] op_sel_hi:[1,1,1]
    v_pk_fma_f32 v[90:91], v[98:99], v[74:75], v[90:91] op_sel:[0,1,0] op_sel_hi:[1,1,1]
    v_pk_fma_f32 v[92:93], v[100:101], v[74:75], v[92:93] op_sel:[0,1,0] op_sel_hi:[1,1,1]
    v_pk_fma_f32 v[94:95], v[102:103], v[74:75], v[94:95] op_sel:[0,1,0] op_sel_hi:[1,1,1]
    s_waitcnt vmcnt(4)
    v_lshlrev_b32 v96, 16, v24
    v_and_b32 v97, 0xffff0000, v24
    v_lshlrev_b32 v98, 16, v25
    v_and_b32 v99, 0xffff0000, v25
    v_lshlrev_b32 v100, 16, v26
    v_and_b32 v101, 0xffff0000, v26
    v_lshlrev_b32 v102, 16, v27
    v_and_b32 v103, 0xffff0000, v27
    v_pk_fma_f32 v[88:89], v[96:97], v[76:77], v[88:89] op_sel_hi:[1,0,1]
    v_pk_fma_f32 v[90:91], v[98:99], v[76:77], v[90:91] op_sel_hi:[1,0,1]
    v_pk_fma_f32 v[92:93], v[100:101], v[76:77], v[92:93] op_sel_hi:[1,0,1]
    v_pk_fma_f32 v[94:95], v[102:103], v[76:77], v[94:95] op_sel_hi:[1,0,1]
    s_waitcnt vmcnt(3)
    global_load_dwordx2 v[112:113], v119, s[14:15] sc1
    v_lshlrev_b32 v96, 16, v28
    v_and_b32 v97, 0xffff0000, v28
    v_lshlrev_b32 v98, 16, v29
    v_and_b32 v99, 0xffff0000, v29
    v_lshlrev_b32 v100, 16, v30
    v_and_b32 v101, 0xffff0000, v30
    v_lshlrev_b32 v102, 16, v31
    v_and_b32 v103, 0xffff0000, v31
    v_pk_fma_f32 v[88:89], v[96:97], v[76:77], v[88:89] op_sel:[0,1,0] op_sel_hi:[1,1,1]
    v_pk_fma_f32 v[90:91], v[98:99], v[76:77], v[90:91] op_sel:[0,1,0] op_sel_hi:[1,1,1]
    v_pk_fma_f32 v[92:93], v[100:101], v[76:77], v[92:93] op_sel:[0,1,0] op_sel_hi:[1,1,1]
    v_pk_fma_f32 v[94:95], v[102:103], v[76:77], v[94:95] op_sel:[0,1,0] op_sel_hi:[1,1,1]
    s_waitcnt vmcnt(3)
    v_lshlrev_b32 v96, 16, v32
    v_and_b32 v97, 0xffff0000, v32
    v_lshlrev_b32 v98, 16, v33
    v_and_b32 v99, 0xffff0000, v33
    v_lshlrev_b32 v100, 16, v34
    v_and_b32 v101, 0xffff0000, v34
    v_lshlrev_b32 v102, 16, v35
    v_and_b32 v103, 0xffff0000, v35
    v_pk_fma_f32 v[88:89], v[96:97], v[78:79], v[88:89] op_sel_hi:[1,0,1]
    v_pk_fma_f32 v[90:91], v[98:99], v[78:79], v[90:91] op_sel_hi:[1,0,1]
    v_pk_fma_f32 v[92:93], v[100:101], v[78:79], v[92:93] op_sel_hi:[1,0,1]
    v_pk_fma_f32 v[94:95], v[102:103], v[78:79], v[94:95] op_sel_hi:[1,0,1]
    s_waitcnt vmcnt(2)
    v_lshlrev_b32 v96, 16, v36
    v_and_b32 v97, 0xffff0000, v36
    v_lshlrev_b32 v98, 16, v37
    v_and_b32 v99, 0xffff0000, v37
    v_lshlrev_b32 v100, 16, v38
    v_and_b32 v101, 0xffff0000, v38
    v_lshlrev_b32 v102, 16, v39
    v_and_b32 v103, 0xffff0000, v39
    v_pk_fma_f32 v[88:89], v[96:97], v[78:79], v[88:89] op_sel:[0,1,0] op_sel_hi:[1,1,1]
    v_pk_fma_f32 v[92:93], v[100:101], v[78:79], v[92:93] op_sel:[0,1,0] op_sel_hi:[1,1,1]
    v_pk_fma_f32 v[90:91], v[98:99], v[78:79], v[90:91] op_sel:[0,1,0] op_sel_hi:[1,1,1]
    v_pk_fma_f32 v[94:95], v[102:103], v[78:79], v[94:95] op_sel:[0,1,0] op_sel_hi:[1,1,1]
    v_permlane32_swap_b32 v88, v92
    v_permlane32_swap_b32 v89, v93
    v_permlane32_swap_b32 v90, v94
    v_permlane32_swap_b32 v91, v95
    v_pk_add_f32 v[88:89], v[88:89], v[92:93]
    v_pk_add_f32 v[90:91], v[90:91], v[94:95]
    s_cmp_lg_u32 s27, 1
    s_nop 0
    v_permlane16_swap_b32 v88, v90
    v_permlane16_swap_b32 v89, v91
    v_pk_add_f32 v[88:89], v[88:89], v[90:91]
    s_cbranch_scc1 L_far
    global_store_dwordx2 v114, v[88:89], s[14:15]
    s_waitcnt vmcnt(1)
L_chkml:
    v_cmp_eq_u32 vcc, -1, v113
    s_cbranch_vccnz L_againml
    global_load_dwordx2 v[108:109], v115, s[14:15] sc1
L_factor:
    v_max_f32_dpp v96, v112, v112 row_ror:8 row_mask:0xf bank_mask:0xf
    s_nop 1
    v_max_f32_dpp v96, v96, v96 row_ror:4 row_mask:0xf bank_mask:0xf
    s_nop 1
    v_max_f32_dpp v96, v96, v96 row_ror:2 row_mask:0xf bank_mask:0xf
    s_nop 1
    v_max_f32_dpp v96, v96, v96 row_ror:1 row_mask:0xf bank_mask:0xf
    v_sub_f32 v96, v112, v96
    v_exp_f32 v96, v96
    s_nop 0
    v_mul_f32 v100, v113, v96
    s_nop 1
    v_add_f32_dpp v100, v100, v100 row_ror:8 row_mask:0xf bank_mask:0xf
    s_nop 1
    v_add_f32_dpp v100, v100, v100 row_ror:4 row_mask:0xf bank_mask:0xf
    s_nop 1
    v_add_f32_dpp v100, v100, v100 row_ror:2 row_mask:0xf bank_mask:0xf
    s_nop 1
    v_add_f32_dpp v100, v100, v100 row_ror:1 row_mask:0xf bank_mask:0xf
    v_rcp_f32 v100, v100
    s_nop 0
    v_mul_f32 v96, v96, v100
L_poll:
    global_load_dwordx2 v[110:111], v115, s[14:15] sc1
    s_waitcnt vmcnt(1)
    v_cmp_eq_u32 vcc, -1, v109
    s_cbranch_vccnz L_again
L_comb:
    v_pk_mul_f32 v[98:99], v[108:109], v[96:97] op_sel_hi:[1,0]
L_comb2:
    s_nop 1
    v_add_f32_dpp v98, v98, v98 row_ror:8 row_mask:0xf bank_mask:0xf
    v_add_f32_dpp v99, v99, v99 row_ror:8 row_mask:0xf bank_mask:0xf
    s_nop 0
    v_add_f32_dpp v98, v98, v98 row_ror:4 row_mask:0xf bank_mask:0xf
    v_add_f32_dpp v99, v99, v99 row_ror:4 row_mask:0xf bank_mask:0xf
    s_nop 0
    v_add_f32_dpp v98, v98, v98 row_ror:2 row_mask:0xf bank_mask:0xf
    v_add_f32_dpp v99, v99, v99 row_ror:2 row_mask:0xf bank_mask:0xf
    s_nop 0
    v_add_f32_dpp v98, v98, v98 row_ror:1 row_mask:0xf bank_mask:0xf
    v_add_f32_dpp v99, v99, v99 row_ror:1 row_mask:0xf bank_mask:0xf
    s_mov_b32 exec_lo, 0x00010001
    s_mov_b32 exec_hi, 0x00010001
    v_cvt_pk_bf16_f32 v98, v98, v99
    global_store_dword v116, v98, s[10:11]
    s_cmp_gt_u32 s27, 1
    s_cbranch_scc1 L_next
L_end:
    s_endpgm
L_again:
    global_load_dwordx2 v[108:109], v115, s[14:15] sc1
    s_waitcnt vmcnt(1)
    v_cmp_eq_u32 vcc, -1, v111
    s_cbranch_vccnz L_again2
    v_pk_mul_f32 v[98:99], v[110:111], v[96:97] op_sel_hi:[1,0]
    s_branch L_comb2
L_again2:
    s_add_u32 s26, s26, 0x10000
    s_cbranch_scc0 L_poll
    s_endpgm
L_againml:
    global_load_dwordx2 v[112:113], v119, s[14:15] sc1
    s_add_u32 s26, s26, 0x10000
    s_waitcnt vmcnt(0)
    s_cbranch_scc0 L_chkml
    s_endpgm
L_modewait:
    ds_read_b32 v117, v2
    s_branch L_mode
L_farml:
    s_add_u32 s14, s14, 0x200000
    s_addc_u32 s15, s15, 0
    global_store_dwordx2 v118, v[104:105], s[14:15] sc1
    s_branch L_mlback
L_far:
    global_store_dwordx2 v114, v[88:89], s[14:15] sc1
    v_mov_b32 v106, 1
    s_mov_b64 exec, 1
    s_waitcnt vmcnt(0)
    global_atomic_add v106, v2, v106, s[12:13] offset:128 sc0 sc1
    s_waitcnt vmcnt(0)
    v_readfirstlane_b32 s30, v106
    s_nop 0
    s_cmp_lg_u32 s30, 15
    s_cbranch_scc1 L_end
    global_store_dword v2, v2, s[12:13] offset:128 sc1
    s_mov_b64 exec, -1
    s_mov_b32 s27, 16
    v_or_b32 v115, 0x1e00, v115
    v_or_b32 v116, 0xcc, v116
    global_load_dwordx2 v[112:113], v119, s[14:15] sc1
    global_load_dwordx2 v[108:109], v115, s[14:15] sc1
    s_waitcnt vmcnt(0)
    s_branch L_factor
L_next:
    s_mov_b64 exec, -1
    s_sub_u32 s27, s27, 1
    v_subrev_u32 v115, 0x200, v115
    global_load_dwordx2 v[108:109], v115, s[14:15] sc1
    s_sub_u32 s30, s27, 1
    s_and_b32 s31, s30, 3
    s_lshl_b32 s31, s31, 6
    s_and_b32 s30, s30, 12
    s_or_b32 s30, s30, s31
    v_and_b32 v116, 0xffffff33, v116
    v_or_b32 v116, s30, v116
    s_waitcnt vmcnt(0)
    s_branch L_comb
.section .rodata,"a"
.p2align 6
.amdhsa_kernel standalone__mha_softmax__decode_kernel
  .amdhsa_next_free_vgpr 120
  .amdhsa_next_free_sgpr 48
  .amdhsa_accum_offset 120
  .amdhsa_group_segment_fixed_size 0
  .amdhsa_kernarg_size 48
  .amdhsa_user_sgpr_count 2
  .amdhsa_user_sgpr_kernarg_segment_ptr 1
  .amdhsa_system_sgpr_workgroup_id_x 1
  .amdhsa_float_denorm_mode_32 3
.end_amdhsa_kernel
```
